```python
import torch

def _softmax(x, axis=-1):
    return torch.softmax(x, dim=axis)
def _gelu(x):
    return torch.nn.functional.gelu(x, approximate="tanh")
def _silu(x):
    return torch.nn.functional.silu(x)
def _sigmoid(x):
    return torch.sigmoid(x)
def _layernorm(x, axis=-1, eps=1e-5):
    m = x.mean(dim=axis, keepdim=True)
    v = x.var(dim=axis, keepdim=True, unbiased=False)
    return (x - m) / torch.sqrt(v + eps)
def _scatter_add(tgt, idx, src, axis=0):
    return tgt.clone().index_add_(axis, idx, src)
def _segment_sum(src, seg, n):
    out = torch.zeros((n,) + src.shape[1:], dtype=src.dtype)
    return out.index_add_(0, seg, src)
def _pad(x, pw):
    flat = tuple(v for pair in reversed(pw) for v in pair)
    return torch.nn.functional.pad(x, flat)

kernel_name = 'parallel_sum__mha_block_cached__glu_gated_bilinear__decode'

def setup_inputs():

    _w = (lambda a: (lambda t: t.to(torch.bfloat16) if t.is_floating_point() else t)(torch.as_tensor(a)))
    def _A_setup():
        B, Sq, D = 1, 1, 640
        H, Sk, Dh = 32, 32768, 192
        return {
            "x": _w((lambda *s: torch.randn(*s, dtype=torch.bfloat16) * 0.05)(B, Sq, D)),
            "k_cache": _w((lambda *s: torch.randn(*s, dtype=torch.bfloat16) * 3.2)(B, H, Sk, Dh)),
            "v_cache": _w((lambda *s: torch.randn(*s, dtype=torch.bfloat16) * 1.6)(B, H, Sk, Dh)),
            "wq": _w((lambda *s: torch.randn(*s, dtype=torch.bfloat16) * 3.2)(D, H * Dh) * (D ** -0.5)),
            "wo": _w((lambda *s: torch.randn(*s, dtype=torch.bfloat16) * 1.6)(H * Dh, D) * ((H * Dh) ** -0.5)),
        }
    _A_in = _A_setup()

    def _B_setup():
        B, S, D, F = 1, 1, 640, 1536
        return {
            "x": _w((lambda *s: torch.randn(*s, dtype=torch.bfloat16) * 0.05)(B, S, D)),
            "w_gate": _w((lambda *s: torch.randn(*s, dtype=torch.bfloat16) * 1.6)(D, F) * (D ** -0.5)),
            "w_up": _w((lambda *s: torch.randn(*s, dtype=torch.bfloat16) * 1.6)(D, F) * (D ** -0.5)),
            "w_down": _w((lambda *s: torch.randn(*s, dtype=torch.bfloat16) * 1.6)(F, D) * (F ** -0.5)),
        }
    _B_in = _B_setup()

    return {
        "A_x": _A_in["x"],
        "A_k_cache": _A_in["k_cache"],
        "A_v_cache": _A_in["v_cache"],
        "A_wq": _A_in["wq"],
        "A_wo": _A_in["wo"],
        "B_x": _B_in["x"],
        "B_w_gate": _B_in["w_gate"],
        "B_w_up": _B_in["w_up"],
        "B_w_down": _B_in["w_down"],
    }

def reference(A_x, A_k_cache, A_v_cache, A_wq, A_wo, B_x, B_w_gate, B_w_up, B_w_down):
    def _A_ref(x, k_cache, v_cache, wq, wo):
        B, Sq, D = x.shape
        H, Dh = 32, 192
        q = (lambda x, *d: x.permute(*d))((x @ wq).reshape(B, Sq, H, Dh), 0, 2, 1, 3)
        scores = torch.einsum("bhqd,bhkd->bhqk", q, k_cache) * (Dh ** -0.5)
        p = _softmax(scores, axis=-1)
        o = torch.einsum("bhqk,bhkd->bhqd", p, v_cache)
        return (lambda x, *d: x.permute(*d))(o, 0, 2, 1, 3).reshape(B, Sq, H * Dh) @ wo

    def _B_ref(x, w_gate, w_up, w_down):
        g = torch.einsum("bsd,df->bsf", x, w_gate)
        u = torch.einsum("bsd,df->bsf", x, w_up)
        h = g * u
        return torch.einsum("bsf,fd->bsd", h, w_down)

    x = A_x
    xn = _layernorm(x, axis=-1)
    return x + _A_ref(xn, A_k_cache, A_v_cache, A_wq, A_wo) + _B_ref(xn, B_w_gate, B_w_up, B_w_down)
```

```asm
; @launch grid=(256,1,1) block=(512,1,1) lds=33280
.amdgcn_target "amdgcn-amd-amdhsa--gfx950"
.text
.globl parallel_sum__mha_block_cached__glu_gated_bilinear__decode_kernel
.p2align 8
.type parallel_sum__mha_block_cached__glu_gated_bilinear__decode_kernel,@function
parallel_sum__mha_block_cached__glu_gated_bilinear__decode_kernel:
  s_cmp_ge_u32 s2, 256
  s_cbranch_scc1 L_done
  s_load_dwordx2 s[36:37], s[0:1], 0
  s_load_dwordx4 s[4:7], s[0:1], 8
  s_load_dwordx4 s[48:51], s[0:1], 24
  s_load_dwordx4 s[52:55], s[0:1], 48
  s_load_dwordx4 s[56:59], s[0:1], 64
  s_load_dwordx4 s[60:63], s[0:1], 80
  v_lshrrev_b32 v1, 6, v0
  v_and_b32 v0, 63, v0
  v_readfirstlane_b32 s3, v1
  v_lshrrev_b32 v2, 3, v0
  v_and_b32 v3, 7, v0
  v_mul_u32_u24 v1, 384, v2
  v_lshl_add_u32 v1, v3, 4, v1
  v_and_b32 v8, 1, v0
  v_mov_b32 v9, 0xffff
  v_lshlrev_b32 v8, 4, v8
  v_lshlrev_b32 v9, v8, v9
  v_lshrrev_b32 v8, 1, v3
  v_cmp_eq_u32 vcc, 0, v8
  s_nop 1
  v_cndmask_b32 v4, 0, v9, vcc
  v_cmp_eq_u32 vcc, 1, v8
  s_nop 1
  v_cndmask_b32 v5, 0, v9, vcc
  v_cmp_eq_u32 vcc, 2, v8
  s_nop 1
  v_cndmask_b32 v6, 0, v9, vcc
  v_cmp_eq_u32 vcc, 3, v8
  s_nop 1
  v_cndmask_b32 v7, 0, v9, vcc
  s_and_b32 s32, s2, 31
  s_lshr_b32 s33, s2, 5
  s_and_b32 s40, s32, 7
  s_lshl_b32 s40, s40, 2
  s_lshr_b32 s47, s32, 3
  s_or_b32 s47, s47, s40
  v_lshlrev_b32 v8, 2, v0
  s_mul_i32 s40, s33, 80
  s_lshl_b32 s41, s3, 3
  s_add_u32 s44, s40, s41
  v_add_u32 v10, s44, v2
  v_mul_u32_u24 v10, 12288, v10
  v_lshl_add_u32 v10, v3, 4, v10
  v_add_u32 v152, s44, v2
  v_mul_u32_u24 v152, 3072, v152
  v_lshl_add_u32 v152, v3, 4, v152
  s_waitcnt lgkmcnt(0)
  s_mov_b32 s20, s36
  s_and_b32 s21, s37, 0xffff
  s_mov_b32 s22, 1280
  s_mov_b32 s23, 0x20000
  s_mov_b32 s16, s48
  s_and_b32 s17, s49, 0xffff
  s_mov_b32 s18, 7864320
  s_mov_b32 s19, 0x20000
  s_mov_b32 s8, s4
  s_and_b32 s9, s5, 0xffff
  s_mov_b32 s10, 402653184
  s_mov_b32 s11, 0x20000
  s_mov_b32 s12, s6
  s_and_b32 s13, s7, 0xffff
  s_mov_b32 s14, 402653184
  s_mov_b32 s15, 0x20000
  s_mov_b32 s64, s52
  s_and_b32 s65, s53, 0xffff
  s_mov_b32 s66, 1966080
  s_mov_b32 s67, 0x20000
  s_mov_b32 s68, s54
  s_and_b32 s69, s55, 0xffff
  s_mov_b32 s70, 1966080
  s_mov_b32 s71, 0x20000
  s_cmp_lg_u32 s3, 7
  s_cbranch_scc1 L_nomark
  v_mov_b32 v252, -1
  v_mov_b32 v253, -1
  v_mov_b32 v254, -1
  v_mov_b32 v255, -1
  s_mul_i32 s40, s32, 6144
  s_mul_i32 s41, s33, 768
  s_add_u32 s40, s40, s41
  s_add_u32 s40, s40, 819200
  v_lshl_add_u32 v9, v0, 4, s40
  s_mov_b32 exec_hi, 0xffff
  global_store_dwordx4 v9, v[252:255], s[62:63] sc1
  s_mov_b64 exec, -1
  s_lshl_b32 s40, s32, 13
  s_lshl_b32 s41, s33, 7
  s_add_u32 s40, s40, s41
  v_lshl_add_u32 v9, v2, 10, s40
  v_lshl_add_u32 v9, v3, 4, v9
  global_store_dwordx4 v9, v[252:255], s[62:63] sc1
  s_mul_i32 s40, s33, 20480
  s_add_u32 s40, s40, 262144
  s_mul_i32 s41, s32, 640
  s_add_u32 s40, s40, s41
  v_lshl_add_u32 v9, v0, 4, s40
  s_mov_b32 exec_hi, 0xff
  global_store_dwordx4 v9, v[252:255], s[62:63] sc1
  s_mov_b64 exec, -1
  s_lshl_b32 s40, s47, 12
  s_lshl_b32 s41, s33, 9
  s_add_u32 s40, s40, s41
  s_add_u32 s40, s40, 458752
  v_lshl_add_u32 v9, v0, 4, s40
  s_mov_b32 exec_hi, 0
  global_store_dwordx4 v9, v[252:255], s[62:63] sc1
  s_mov_b64 exec, -1
  s_cmp_lg_u32 s32, 0
  s_cbranch_scc1 L_nomark
  s_mul_i32 s40, s33, 4352
  s_add_u32 s40, s40, 655360
  v_mov_b32 v9, s40
  v_mov_b32 v252, 0
  s_mov_b64 exec, 1
  global_store_dword v9, v252, s[62:63] sc1
  s_mov_b64 exec, -1
L_nomark:
  buffer_load_dword v11, v8, s[20:23], 0 offen offset:0
  buffer_load_dword v12, v8, s[20:23], 0 offen offset:256
  buffer_load_dword v13, v8, s[20:23], 0 offen offset:512
  buffer_load_dword v14, v8, s[20:23], 0 offen offset:768
  buffer_load_dword v15, v8, s[20:23], 0 offen offset:1024
  s_mul_i32 s41, s32, 384
  s_mul_i32 s40, s47, 96
  buffer_load_dwordx4 v[112:115], v10, s[16:19], s41 offen offset:0 nt
  buffer_load_dwordx4 v[116:119], v10, s[16:19], s41 offen offset:128 nt
  buffer_load_dwordx4 v[120:123], v10, s[16:19], s41 offen offset:256 nt
  s_mov_b32 exec_lo, 0x3f3f3f3f
  s_mov_b32 exec_hi, 0x3f3f3f3f
  buffer_load_dwordx4 v[136:139], v152, s[64:67], s40 offen nt
  buffer_load_dwordx4 v[140:143], v152, s[68:71], s40 offen nt
  s_mov_b64 exec, -1
  s_cmp_ge_u32 s3, 2
  s_cbranch_scc1 L_g1_one
  s_add_u32 s40, s40, 196608
  s_add_u32 s41, s41, 786432
  buffer_load_dwordx4 v[124:127], v10, s[16:19], s41 offen offset:0 nt
  buffer_load_dwordx4 v[128:131], v10, s[16:19], s41 offen offset:128 nt
  buffer_load_dwordx4 v[132:135], v10, s[16:19], s41 offen offset:256 nt
  s_mov_b32 exec_lo, 0x3f3f3f3f
  s_mov_b32 exec_hi, 0x3f3f3f3f
  buffer_load_dwordx4 v[144:147], v152, s[64:67], s40 offen nt
  buffer_load_dwordx4 v[148:151], v152, s[68:71], s40 offen nt
  s_mov_b64 exec, -1
L_g1_one:
  s_mul_i32 s29, s32, 12582912
  s_mov_b32 s28, 128
  s_mul_i32 s41, s33, 98304
  s_add_u32 s29, s29, s41
  s_lshr_b32 s24, s3, 3
  s_mul_i32 s24, s24, 786432
  s_and_b32 s25, s3, 7
  s_mul_i32 s25, s25, 12288
  s_add_u32 s24, s24, s25
  s_add_u32 s24, s24, s29
  s_add_u32 s25, s24, 6144
  s_cmp_lg_u32 s3, 7
  s_cbranch_scc1 L_noreport
  s_waitcnt vmcnt(10)
  s_lshl_b32 s40, s32, 3
  v_mov_b32 v8, s40
  v_mov_b32 v9, 1
  s_mov_b64 exec, 1
  global_atomic_add v8, v9, s[60:61]
  s_mov_b64 exec, -1
L_noreport:
  s_barrier
  buffer_load_dwordx4 v[16:19], v1, s[8:11], s24 offen offset:0 nt
  buffer_load_dwordx4 v[20:23], v1, s[8:11], s24 offen offset:128 nt
  buffer_load_dwordx4 v[24:27], v1, s[8:11], s24 offen offset:256 nt
  buffer_load_dwordx4 v[28:31], v1, s[8:11], s24 offen offset:3072 nt
  buffer_load_dwordx4 v[32:35], v1, s[8:11], s24 offen offset:3200 nt
  buffer_load_dwordx4 v[36:39], v1, s[8:11], s24 offen offset:3328 nt
  s_waitcnt vmcnt(11)
  v_lshlrev_b32 v232, 16, v11
  v_and_b32 v233, 0xffff0000, v11
  v_lshlrev_b32 v234, 16, v12
  v_and_b32 v235, 0xffff0000, v12
  v_lshlrev_b32 v236, 16, v13
  v_and_b32 v237, 0xffff0000, v13
  v_lshlrev_b32 v238, 16, v14
  v_and_b32 v239, 0xffff0000, v14
  v_lshlrev_b32 v240, 16, v15
  v_and_b32 v241, 0xffff0000, v15
  v_add_f32 v8, v232, v233
  v_add_f32 v8, v8, v234
  v_add_f32 v8, v8, v235
  v_add_f32 v8, v8, v236
  v_add_f32 v8, v8, v237
  v_add_f32 v8, v8, v238
  v_add_f32 v8, v8, v239
  v_add_f32 v8, v8, v240
  v_add_f32 v8, v8, v241
  s_nop 1
  v_add_f32_dpp v8, v8, v8 quad_perm:[1,0,3,2] row_mask:0xf bank_mask:0xf
  s_nop 1
  v_add_f32_dpp v8, v8, v8 quad_perm:[2,3,0,1] row_mask:0xf bank_mask:0xf
  s_nop 1
  v_add_f32_dpp v8, v8, v8 row_half_mirror row_mask:0xf bank_mask:0xf
  s_nop 1
  v_add_f32_dpp v8, v8, v8 row_mirror row_mask:0xf bank_mask:0xf
  v_mov_b32 v9, v8
  s_nop 1
  v_permlane16_swap_b32 v8, v9
  v_add_f32 v8, v8, v9
  v_mov_b32 v9, v8
  s_nop 1
  v_permlane32_swap_b32 v8, v9
  v_add_f32 v8, v8, v9
  v_mul_f32 v8, 0x3acccccd, v8
  v_sub_f32 v9, v232, v8
  v_mul_f32 v11, v9, v9
  v_sub_f32 v9, v233, v8
  v_fmac_f32 v11, v9, v9
  v_sub_f32 v9, v234, v8
  v_fmac_f32 v11, v9, v9
  v_sub_f32 v9, v235, v8
  v_fmac_f32 v11, v9, v9
  v_sub_f32 v9, v236, v8
  v_fmac_f32 v11, v9, v9
  v_sub_f32 v9, v237, v8
  v_fmac_f32 v11, v9, v9
  v_sub_f32 v9, v238, v8
  v_fmac_f32 v11, v9, v9
  v_sub_f32 v9, v239, v8
  v_fmac_f32 v11, v9, v9
  v_sub_f32 v9, v240, v8
  v_fmac_f32 v11, v9, v9
  v_sub_f32 v9, v241, v8
  v_fmac_f32 v11, v9, v9
  s_nop 1
  v_add_f32_dpp v11, v11, v11 quad_perm:[1,0,3,2] row_mask:0xf bank_mask:0xf
  s_nop 1
  v_add_f32_dpp v11, v11, v11 quad_perm:[2,3,0,1] row_mask:0xf bank_mask:0xf
  s_nop 1
  v_add_f32_dpp v11, v11, v11 row_half_mirror row_mask:0xf bank_mask:0xf
  s_nop 1
  v_add_f32_dpp v11, v11, v11 row_mirror row_mask:0xf bank_mask:0xf
  v_mov_b32 v9, v11
  s_nop 1
  v_permlane16_swap_b32 v11, v9
  v_add_f32 v11, v11, v9
  v_mov_b32 v9, v11
  s_nop 1
  v_permlane32_swap_b32 v11, v9
  v_add_f32 v11, v11, v9
  v_mul_f32 v11, 0x3acccccd, v11
  v_cvt_pk_bf16_f32 v11, v11, v11
  v_and_b32 v11, 0xffff0000, v11
  v_add_f32 v11, 0x3727c5ac, v11
  v_cvt_pk_bf16_f32 v11, v11, v11
  v_and_b32 v11, 0xffff0000, v11
  v_sqrt_f32 v11, v11
  s_nop 0
  v_cvt_pk_bf16_f32 v11, v11, v11
  v_and_b32 v11, 0xffff0000, v11
  v_cvt_pk_bf16_f32 v8, v8, v8
  v_and_b32 v8, 0xffff0000, v8
  v_rcp_f32 v12, v11
  v_sub_f32 v232, v232, v8
  v_sub_f32 v233, v233, v8
  v_sub_f32 v234, v234, v8
  v_sub_f32 v235, v235, v8
  v_sub_f32 v236, v236, v8
  v_sub_f32 v237, v237, v8
  v_sub_f32 v238, v238, v8
  v_sub_f32 v239, v239, v8
  v_sub_f32 v240, v240, v8
  v_sub_f32 v241, v241, v8
  v_cvt_pk_bf16_f32 v13, v232, v233
  v_lshlrev_b32 v232, 16, v13
  v_and_b32 v233, 0xffff0000, v13
  v_cvt_pk_bf16_f32 v13, v234, v235
  v_lshlrev_b32 v234, 16, v13
  v_and_b32 v235, 0xffff0000, v13
  v_cvt_pk_bf16_f32 v13, v236, v237
  v_lshlrev_b32 v236, 16, v13
  v_and_b32 v237, 0xffff0000, v13
  v_cvt_pk_bf16_f32 v13, v238, v239
  v_lshlrev_b32 v238, 16, v13
  v_and_b32 v239, 0xffff0000, v13
  v_cvt_pk_bf16_f32 v13, v240, v241
  v_lshlrev_b32 v240, 16, v13
  v_and_b32 v241, 0xffff0000, v13
  v_mul_f32 v13, v232, v12
  v_fma_f32 v14, -v13, v11, v232
  v_fma_f32 v232, v14, v12, v13
  v_mul_f32 v13, v233, v12
  v_fma_f32 v14, -v13, v11, v233
  v_fma_f32 v233, v14, v12, v13
  v_mul_f32 v13, v234, v12
  v_fma_f32 v14, -v13, v11, v234
  v_fma_f32 v234, v14, v12, v13
  v_mul_f32 v13, v235, v12
  v_fma_f32 v14, -v13, v11, v235
  v_fma_f32 v235, v14, v12, v13
  v_mul_f32 v13, v236, v12
  v_fma_f32 v14, -v13, v11, v236
  v_fma_f32 v236, v14, v12, v13
  v_mul_f32 v13, v237, v12
  v_fma_f32 v14, -v13, v11, v237
  v_fma_f32 v237, v14, v12, v13
  v_mul_f32 v13, v238, v12
  v_fma_f32 v14, -v13, v11, v238
  v_fma_f32 v238, v14, v12, v13
  v_mul_f32 v13, v239, v12
  v_fma_f32 v14, -v13, v11, v239
  v_fma_f32 v239, v14, v12, v13
  v_mul_f32 v13, v240, v12
  v_fma_f32 v14, -v13, v11, v240
  v_fma_f32 v240, v14, v12, v13
  v_mul_f32 v13, v241, v12
  v_fma_f32 v14, -v13, v11, v241
  v_fma_f32 v241, v14, v12, v13
  v_lshlrev_b32 v9, 3, v0
  s_mov_b32 s40, 0x01000100
  s_mov_b32 s41, 0x03020302
  v_cvt_pk_bf16_f32 v13, v232, v233
  v_perm_b32 v232, v13, v13, s40
  v_perm_b32 v233, v13, v13, s41
  ds_write_b64 v9, v[232:233] offset:0
  v_cvt_pk_bf16_f32 v13, v234, v235
  v_perm_b32 v234, v13, v13, s40
  v_perm_b32 v235, v13, v13, s41
  ds_write_b64 v9, v[234:235] offset:512
  v_cvt_pk_bf16_f32 v13, v236, v237
  v_perm_b32 v236, v13, v13, s40
  v_perm_b32 v237, v13, v13, s41
  ds_write_b64 v9, v[236:237] offset:1024
  v_cvt_pk_bf16_f32 v13, v238, v239
  v_perm_b32 v238, v13, v13, s40
  v_perm_b32 v239, v13, v13, s41
  ds_write_b64 v9, v[238:239] offset:1536
  v_cvt_pk_bf16_f32 v13, v240, v241
  v_perm_b32 v240, v13, v13, s40
  v_perm_b32 v241, v13, v13, s41
  ds_write_b64 v9, v[240:241] offset:2048
  v_mov_b32 v13, 16
  v_mov_b32 v14, 0
  ds_write_b32 v14, v13 offset:3328
  s_lshl_b32 s40, s44, 2
  v_lshl_add_u32 v9, v2, 2, s40
  s_waitcnt lgkmcnt(0)
  ds_read_b32 v160, v9 offset:0
  ds_read_b32 v161, v9 offset:256
  s_waitcnt lgkmcnt(0)
  v_and_b32 v12, v160, v4
  v_and_b32 v13, v160, v5
  v_and_b32 v14, v160, v6
  v_and_b32 v15, v160, v7
  s_cmp_eq_u32 s3, 7
  s_cbranch_scc1 L_w7wait
  s_waitcnt vmcnt(6)
  s_branch L_wdone
L_w7wait:
  s_waitcnt vmcnt(7)
L_wdone:
  v_mfma_f32_16x16x32_bf16 v[244:247], v[112:115], v[12:15], 0
  v_mfma_f32_16x16x32_bf16 v[248:251], v[116:119], v[12:15], 0
  v_mfma_f32_16x16x32_bf16 v[252:255], v[120:123], v[12:15], 0
  v_mfma_f32_16x16x32_bf16 v[152:155], v[136:139], v[12:15], 0
  v_mfma_f32_16x16x32_bf16 v[156:159], v[140:143], v[12:15], 0
  s_cmp_ge_u32 s3, 2
  s_cbranch_scc1 L_g1_mm
  v_and_b32 v8, v161, v4
  v_and_b32 v9, v161, v5
  v_and_b32 v10, v161, v6
  v_and_b32 v11, v161, v7
  s_nop 1
  v_mfma_f32_16x16x32_bf16 v[244:247], v[124:127], v[8:11], v[244:247]
  v_mfma_f32_16x16x32_bf16 v[248:251], v[128:131], v[8:11], v[248:251]
  v_mfma_f32_16x16x32_bf16 v[252:255], v[132:135], v[8:11], v[252:255]
  v_mfma_f32_16x16x32_bf16 v[152:155], v[144:147], v[8:11], v[152:155]
  v_mfma_f32_16x16x32_bf16 v[156:159], v[148:151], v[8:11], v[156:159]
L_g1_mm:
  v_lshrrev_b32 v8, 5, v0
  s_lshl_b32 s40, s3, 1
  v_add_u32 v8, s40, v8
  v_mul_u32_u24 v8, 768, v8
  v_bfe_u32 v9, v0, 4, 1
  v_lshl_add_u32 v8, v9, 7, v8
  v_lshl_add_u32 v9, v3, 2, v8
  s_mov_b32 exec_lo, 0x00ff00ff
  s_mov_b32 exec_hi, 0xff00ff00
  ds_write_b32 v9, v244 offset:4096
  ds_write_b32 v9, v245 offset:4128
  ds_write_b32 v9, v246 offset:4160
  ds_write_b32 v9, v247 offset:4192
  ds_write_b32 v9, v248 offset:4352
  ds_write_b32 v9, v249 offset:4384
  ds_write_b32 v9, v250 offset:4416
  ds_write_b32 v9, v251 offset:4448
  ds_write_b32 v9, v252 offset:4608
  ds_write_b32 v9, v253 offset:4640
  ds_write_b32 v9, v254 offset:4672
  ds_write_b32 v9, v255 offset:4704
  s_mov_b64 exec, -1
  v_lshrrev_b32 v8, 5, v0
  s_lshl_b32 s40, s3, 1
  v_add_u32 v8, s40, v8
  v_mul_u32_u24 v8, 512, v8
  v_bfe_u32 v9, v0, 4, 1
  v_lshl_add_u32 v8, v9, 7, v8
  v_lshl_add_u32 v9, v3, 2, v8
  s_mov_b32 exec_lo, 0x00ff00ff
  s_mov_b32 exec_hi, 0xff00ff00
  ds_write_b32 v9, v152 offset:20480
  ds_write_b32 v9, v153 offset:20512
  ds_write_b32 v9, v154 offset:20544
  ds_write_b32 v9, v155 offset:20576
  ds_write_b32 v9, v156 offset:20736
  ds_write_b32 v9, v157 offset:20768
  ds_write_b32 v9, v158 offset:20800
  ds_write_b32 v9, v159 offset:20832
  s_mov_b64 exec, -1
  s_waitcnt lgkmcnt(0)
  s_barrier
  s_cmp_eq_u32 s3, 6
  s_cbranch_scc1 L_askmarks
  s_cmp_ge_u32 s3, 5
  s_cbranch_scc1 L_pub_done
  s_cmp_ge_u32 s3, 3
  s_cbranch_scc1 L_gsum
  s_lshl_b32 s40, s3, 8
  v_lshl_add_u32 v9, v0, 2, s40
  ds_read_b32 v176, v9 offset:4096
  ds_read_b32 v177, v9 offset:4864
  ds_read_b32 v178, v9 offset:5632
  ds_read_b32 v179, v9 offset:6400
  ds_read_b32 v180, v9 offset:7168
  ds_read_b32 v181, v9 offset:7936
  ds_read_b32 v182, v9 offset:8704
  ds_read_b32 v183, v9 offset:9472
  ds_read_b32 v184, v9 offset:10240
  ds_read_b32 v185, v9 offset:11008
  ds_read_b32 v186, v9 offset:11776
  ds_read_b32 v187, v9 offset:12544
  ds_read_b32 v188, v9 offset:13312
  ds_read_b32 v189, v9 offset:14080
  ds_read_b32 v190, v9 offset:14848
  ds_read_b32 v191, v9 offset:15616
  s_mul_i32 s40, s32, 6144
  s_mul_i32 s41, s33, 768
  s_add_u32 s40, s40, s41
  s_lshl_b32 s41, s3, 8
  s_add_u32 s40, s40, s41
  s_add_u32 s40, s40, 819200
  v_lshl_add_u32 v10, v0, 2, s40
  s_waitcnt lgkmcnt(0)
  v_add_f32 v176, v176, v177
  v_add_f32 v178, v178, v179
  v_add_f32 v180, v180, v181
  v_add_f32 v182, v182, v183
  v_add_f32 v184, v184, v185
  v_add_f32 v186, v186, v187
  v_add_f32 v188, v188, v189
  v_add_f32 v190, v190, v191
  v_add_f32 v176, v176, v178
  v_add_f32 v180, v180, v182
  v_add_f32 v184, v184, v186
  v_add_f32 v188, v188, v190
  v_add_f32 v176, v176, v180
  v_add_f32 v184, v184, v188
  v_add_f32 v176, v176, v184
  global_store_dword v10, v176, s[62:63] sc1
  s_branch L_pub_done
L_gsum:
  s_sub_u32 s40, s3, 3
  s_lshl_b32 s40, s40, 8
  v_lshl_add_u32 v9, v0, 2, s40
  ds_read_b32 v176, v9 offset:20480
  ds_read_b32 v177, v9 offset:20992
  ds_read_b32 v178, v9 offset:21504
  ds_read_b32 v179, v9 offset:22016
  ds_read_b32 v180, v9 offset:22528
  ds_read_b32 v181, v9 offset:23040
  ds_read_b32 v182, v9 offset:23552
  ds_read_b32 v183, v9 offset:24064
  ds_read_b32 v184, v9 offset:24576
  ds_read_b32 v185, v9 offset:25088
  ds_read_b32 v186, v9 offset:25600
  ds_read_b32 v187, v9 offset:26112
  ds_read_b32 v188, v9 offset:26624
  ds_read_b32 v189, v9 offset:27136
  ds_read_b32 v190, v9 offset:27648
  ds_read_b32 v191, v9 offset:28160
  s_lshl_b32 s41, s47, 12
  s_lshl_b32 s42, s33, 9
  s_add_u32 s41, s41, s42
  s_add_u32 s41, s41, 458752
  v_add_u32 v9, s41, v9
  s_waitcnt lgkmcnt(0)
  v_add_f32 v176, v176, v177
  v_add_f32 v178, v178, v179
  v_add_f32 v180, v180, v181
  v_add_f32 v182, v182, v183
  v_add_f32 v184, v184, v185
  v_add_f32 v186, v186, v187
  v_add_f32 v188, v188, v189
  v_add_f32 v190, v190, v191
  v_add_f32 v176, v176, v178
  v_add_f32 v180, v180, v182
  v_add_f32 v184, v184, v186
  v_add_f32 v188, v188, v190
  v_add_f32 v176, v176, v180
  v_add_f32 v184, v184, v188
  v_add_f32 v176, v176, v184
  s_mov_b32 exec_hi, 65535
  global_store_dword v9, v176, s[62:63] sc1
  s_mov_b64 exec, -1
  s_branch L_pub_done
L_askmarks:
  s_lshl_b32 s40, s32, 3
  v_mov_b32 v10, s40
  s_mov_b64 exec, 1
  global_load_dword v176, v10, s[60:61] sc1
  s_mov_b64 exec, -1
L_pub_done:
  s_barrier
  buffer_load_dwordx4 v[40:43], v1, s[8:11], s25 offen offset:0 nt
  buffer_load_dwordx4 v[44:47], v1, s[8:11], s25 offen offset:128 nt
  buffer_load_dwordx4 v[48:51], v1, s[8:11], s25 offen offset:256 nt
  buffer_load_dwordx4 v[52:55], v1, s[8:11], s25 offen offset:3072 nt
  buffer_load_dwordx4 v[56:59], v1, s[8:11], s25 offen offset:3200 nt
  buffer_load_dwordx4 v[60:63], v1, s[8:11], s25 offen offset:3328 nt
  s_cmp_lg_u32 s3, 6
  s_cbranch_scc1 L_marks_done
  s_mov_b32 s46, 0
  s_waitcnt vmcnt(6)
L_marks:
  v_readfirstlane_b32 s40, v176
  s_nop 0
  s_cmp_ge_u32 s40, 8
  s_cbranch_scc1 L_marks_done
  s_cmp_ge_u32 s46, 20000
  s_cbranch_scc1 L_marks_done
  s_add_u32 s46, s46, 1
  s_mov_b64 exec, 1
  global_load_dword v176, v10, s[60:61] sc1
  s_mov_b64 exec, -1
  s_waitcnt vmcnt(0)
  s_branch L_marks
L_marks_done:
  s_barrier
  s_cmp_ge_u32 s3, 3
  s_cbranch_scc1 L_qask_done
  s_mul_i32 s40, s32, 6144
  s_lshl_b32 s41, s3, 8
  s_add_u32 s40, s40, s41
  s_add_u32 s40, s40, 822272
  v_lshl_add_u32 v10, v0, 2, s40
  global_load_dword v176, v10, s[62:63] offset:-3072 sc1
  global_load_dword v177, v10, s[62:63] offset:-2304 sc1
  global_load_dword v178, v10, s[62:63] offset:-1536 sc1
  global_load_dword v179, v10, s[62:63] offset:-768 sc1
  global_load_dword v180, v10, s[62:63] offset:0 sc1
  global_load_dword v181, v10, s[62:63] offset:768 sc1
  global_load_dword v182, v10, s[62:63] offset:1536 sc1
  global_load_dword v183, v10, s[62:63] offset:2304 sc1
L_qask_done:
  s_barrier
  buffer_load_dwordx4 v[64:67], v1, s[12:15], s24 offen offset:0 nt
  buffer_load_dwordx4 v[68:71], v1, s[12:15], s24 offen offset:128 nt
  buffer_load_dwordx4 v[72:75], v1, s[12:15], s24 offen offset:256 nt
  buffer_load_dwordx4 v[76:79], v1, s[12:15], s24 offen offset:3072 nt
  buffer_load_dwordx4 v[80:83], v1, s[12:15], s24 offen offset:3200 nt
  buffer_load_dwordx4 v[84:87], v1, s[12:15], s24 offen offset:3328 nt
  s_cmp_ge_u32 s3, 3
  s_cbranch_scc1 L_qsum_done
  s_mov_b32 s46, 0
  s_waitcnt vmcnt(6)
L_qpoll:
  v_cmp_eq_u32 vcc, -1, v176
  v_cmp_eq_u32 s[40:41], -1, v177
  s_nop 0
  s_or_b64 vcc, vcc, s[40:41]
  v_cmp_eq_u32 s[40:41], -1, v178
  s_nop 0
  s_or_b64 vcc, vcc, s[40:41]
  v_cmp_eq_u32 s[40:41], -1, v179
  s_nop 0
  s_or_b64 vcc, vcc, s[40:41]
  v_cmp_eq_u32 s[40:41], -1, v180
  s_nop 0
  s_or_b64 vcc, vcc, s[40:41]
  v_cmp_eq_u32 s[40:41], -1, v181
  s_nop 0
  s_or_b64 vcc, vcc, s[40:41]
  v_cmp_eq_u32 s[40:41], -1, v182
  s_nop 0
  s_or_b64 vcc, vcc, s[40:41]
  v_cmp_eq_u32 s[40:41], -1, v183
  s_nop 0
  s_or_b64 vcc, vcc, s[40:41]
  s_cbranch_vccz L_qpoll_done
  s_cmp_ge_u32 s46, 20000
  s_cbranch_scc1 L_qpoll_done
  s_add_u32 s46, s46, 1
  global_load_dword v176, v10, s[62:63] offset:-3072 sc1
  global_load_dword v177, v10, s[62:63] offset:-2304 sc1
  global_load_dword v178, v10, s[62:63] offset:-1536 sc1
  global_load_dword v179, v10, s[62:63] offset:-768 sc1
  global_load_dword v180, v10, s[62:63] offset:0 sc1
  global_load_dword v181, v10, s[62:63] offset:768 sc1
  global_load_dword v182, v10, s[62:63] offset:1536 sc1
  global_load_dword v183, v10, s[62:63] offset:2304 sc1
  s_waitcnt vmcnt(0)
  s_branch L_qpoll
L_qpoll_done:
  v_add_f32 v176, v176, v177
  v_add_f32 v178, v178, v179
  v_add_f32 v180, v180, v181
  v_add_f32 v182, v182, v183
  v_add_f32 v176, v176, v178
  v_add_f32 v180, v180, v182
  v_add_f32 v176, v176, v180
  v_cvt_pk_bf16_f32 v176, v176, v176
  s_lshl_b32 s40, s3, 7
  v_lshl_add_u32 v9, v0, 1, s40
  ds_write_b16 v9, v176 offset:2816
  s_waitcnt lgkmcnt(0)
L_qsum_done:
  s_barrier
  buffer_load_dwordx4 v[88:91], v1, s[12:15], s25 offen offset:0 nt
  buffer_load_dwordx4 v[92:95], v1, s[12:15], s25 offen offset:128 nt
  buffer_load_dwordx4 v[96:99], v1, s[12:15], s25 offen offset:256 nt
  buffer_load_dwordx4 v[100:103], v1, s[12:15], s25 offen offset:3072 nt
  buffer_load_dwordx4 v[104:107], v1, s[12:15], s25 offen offset:3200 nt
  buffer_load_dwordx4 v[108:111], v1, s[12:15], s25 offen offset:3328 nt
  v_lshlrev_b32 v9, 4, v3
  ds_read_b128 v[232:235], v9 offset:2816
  ds_read_b128 v[236:239], v9 offset:2944
  ds_read_b128 v[240:243], v9 offset:3072
  s_mov_b32 s16, s50
  s_and_b32 s17, s51, 0xffff
  s_mov_b32 s18, 7864320
  s_mov_b32 s19, 0x20000
  s_mov_b32 s68, s56
  s_and_b32 s69, s57, 0xffff
  s_mov_b32 s70, 1966080
  s_mov_b32 s71, 0x20000
  s_mul_i32 s40, s3, 24
  v_add_u32 v10, s40, v2
  v_mul_u32_u24 v10, 1280, v10
  v_lshl_add_u32 v10, v3, 4, v10
  s_min_u32 s40, s3, 5
  s_lshl_b32 s40, s40, 3
  v_add_u32 v11, s40, v2
  v_mul_u32_u24 v11, 1280, v11
  v_lshl_add_u32 v11, v3, 4, v11
  s_mul_i32 s40, s32, 245760
  s_mul_i32 s42, s47, 61440
  s_lshl_b32 s43, s33, 5
  s_add_u32 s43, s43, 1024
  s_lshl_b32 s41, s33, 7
  s_add_u32 s26, s42, s43
  s_add_u32 s43, s40, s43
  s_add_u32 s40, s40, s41
  s_add_u32 s42, s42, s41
  buffer_load_dwordx4 v[144:147], v10, s[16:19], s40 offen nt
  s_mov_b32 exec_lo, 0x03030303
  s_mov_b32 exec_hi, 0x03030303
  buffer_load_dwordx4 v[148:151], v10, s[16:19], s43 offen nt
  s_mov_b64 exec, -1
  s_add_u32 s40, s40, 10240
  s_add_u32 s43, s43, 10240
  buffer_load_dwordx4 v[152:155], v10, s[16:19], s40 offen nt
  s_mov_b32 exec_lo, 0x03030303
  s_mov_b32 exec_hi, 0x03030303
  buffer_load_dwordx4 v[156:159], v10, s[16:19], s43 offen nt
  s_mov_b64 exec, -1
  s_add_u32 s40, s40, 10240
  s_add_u32 s43, s43, 10240
  buffer_load_dwordx4 v[160:163], v10, s[16:19], s40 offen nt
  buffer_load_dwordx4 v[168:171], v11, s[68:71], s42 offen nt
  s_mov_b32 exec_lo, 0x03030303
  s_mov_b32 exec_hi, 0x03030303
  buffer_load_dwordx4 v[164:167], v10, s[16:19], s43 offen nt
  buffer_load_dwordx4 v[172:175], v11, s[68:71], s26 offen nt
  s_mov_b64 exec, -1
  s_cmp_lt_u32 s3, 4
  s_cbranch_scc1 L_noprio
  s_setprio 1
L_noprio:
L_preloop:
  v_mov_b32 v244, 0
  v_mov_b32 v245, 0
  v_mov_b32 v246, 0
  v_mov_b32 v247, 0
  v_mov_b32 v248, 0
  v_mov_b32 v249, 0
  v_mov_b32 v250, 0
  v_mov_b32 v251, 0
  v_mov_b32 v252, 0
  v_mov_b32 v253, 0
  v_mov_b32 v254, 0
  v_mov_b32 v255, 0
  v_mov_b32 v136, 0x7149f2ca
  v_mov_b32 v137, 0
  v_mov_b32 v139, 1
  v_mov_b32 v140, 0
  s_mov_b32 s30, 0xff800000
  s_mov_b32 s31, 0x3fb8aa3b
  s_add_u32 s27, s3, 8
  s_waitcnt lgkmcnt(0)
  s_sub_u32 s35, s28, 8
  s_min_u32 s41, s3, 5
  s_lshl_b32 s41, s41, 5
  s_lshl_b32 s40, s47, 12
  s_add_u32 s40, s40, s41
  s_add_u32 s40, s40, 458752
  v_lshl_add_u32 v178, v3, 9, s40
  v_lshl_add_u32 v178, v2, 2, v178
  s_mov_b32 s26, 2
L_loop:
  s_cmp_ge_u32 s27, s28
  s_cbranch_scc1 L_last
  s_cmp_ge_u32 s27, s35
  s_cbranch_scc1 L_loop2
  s_sub_u32 s26, s26, 1
  s_cmp_lg_u32 s26, -1
  s_cbranch_scc1 L_nomid
  global_load_dword v176, v178, s[62:63] sc1
  global_load_dword v177, v178, s[62:63] offset:256 sc1
  s_cmp_lg_u32 s3, 1
  s_cbranch_scc1 L_noflag_mid
  global_load_dword v179, v140, s[60:61] sc1
L_noflag_mid:
L_nomid:
  s_lshr_b32 s24, s27, 3
  s_mul_i32 s24, s24, 786432
  s_and_b32 s25, s27, 7
  s_mul_i32 s25, s25, 12288
  s_add_u32 s24, s24, s25
  s_add_u32 s24, s24, s29
  s_add_u32 s25, s24, 6144
  s_waitcnt vmcnt(0)
  v_dot2_f32_bf16 v112, v16, v232, 0
  v_dot2_f32_bf16 v112, v17, v233, v112
  v_dot2_f32_bf16 v112, v18, v234, v112
  v_dot2_f32_bf16 v112, v19, v235, v112
  v_dot2_f32_bf16 v112, v20, v236, v112
  v_dot2_f32_bf16 v112, v21, v237, v112
  v_dot2_f32_bf16 v112, v22, v238, v112
  v_dot2_f32_bf16 v112, v23, v239, v112
  v_dot2_f32_bf16 v112, v24, v240, v112
  v_dot2_f32_bf16 v112, v25, v241, v112
  v_dot2_f32_bf16 v112, v26, v242, v112
  v_dot2_f32_bf16 v112, v27, v243, v112
  buffer_load_dwordx4 v[16:19], v1, s[8:11], s24 offen offset:0 nt
  buffer_load_dwordx4 v[20:23], v1, s[8:11], s24 offen offset:128 nt
  buffer_load_dwordx4 v[24:27], v1, s[8:11], s24 offen offset:256 nt
  s_waitcnt vmcnt(0)
  v_dot2_f32_bf16 v113, v28, v232, 0
  v_dot2_f32_bf16 v113, v29, v233, v113
  v_dot2_f32_bf16 v113, v30, v234, v113
  v_dot2_f32_bf16 v113, v31, v235, v113
  v_dot2_f32_bf16 v113, v32, v236, v113
  v_dot2_f32_bf16 v113, v33, v237, v113
  v_dot2_f32_bf16 v113, v34, v238, v113
  v_dot2_f32_bf16 v113, v35, v239, v113
  v_dot2_f32_bf16 v113, v36, v240, v113
  v_dot2_f32_bf16 v113, v37, v241, v113
  v_dot2_f32_bf16 v113, v38, v242, v113
  v_dot2_f32_bf16 v113, v39, v243, v113
  buffer_load_dwordx4 v[28:31], v1, s[8:11], s24 offen offset:3072 nt
  buffer_load_dwordx4 v[32:35], v1, s[8:11], s24 offen offset:3200 nt
  buffer_load_dwordx4 v[36:39], v1, s[8:11], s24 offen offset:3328 nt
  s_waitcnt vmcnt(0)
  v_dot2_f32_bf16 v114, v40, v232, 0
  v_dot2_f32_bf16 v114, v41, v233, v114
  v_dot2_f32_bf16 v114, v42, v234, v114
  v_dot2_f32_bf16 v114, v43, v235, v114
  v_dot2_f32_bf16 v114, v44, v236, v114
  v_dot2_f32_bf16 v114, v45, v237, v114
  v_dot2_f32_bf16 v114, v46, v238, v114
  v_dot2_f32_bf16 v114, v47, v239, v114
  v_dot2_f32_bf16 v114, v48, v240, v114
  v_dot2_f32_bf16 v114, v49, v241, v114
  v_dot2_f32_bf16 v114, v50, v242, v114
  v_dot2_f32_bf16 v114, v51, v243, v114
  buffer_load_dwordx4 v[40:43], v1, s[8:11], s25 offen offset:0 nt
  buffer_load_dwordx4 v[44:47], v1, s[8:11], s25 offen offset:128 nt
  buffer_load_dwordx4 v[48:51], v1, s[8:11], s25 offen offset:256 nt
  s_waitcnt vmcnt(0)
  v_dot2_f32_bf16 v115, v52, v232, 0
  v_dot2_f32_bf16 v115, v53, v233, v115
  v_dot2_f32_bf16 v115, v54, v234, v115
  v_dot2_f32_bf16 v115, v55, v235, v115
  v_dot2_f32_bf16 v115, v56, v236, v115
  v_dot2_f32_bf16 v115, v57, v237, v115
  v_dot2_f32_bf16 v115, v58, v238, v115
  v_dot2_f32_bf16 v115, v59, v239, v115
  v_dot2_f32_bf16 v115, v60, v240, v115
  v_dot2_f32_bf16 v115, v61, v241, v115
  v_dot2_f32_bf16 v115, v62, v242, v115
  v_dot2_f32_bf16 v115, v63, v243, v115
  buffer_load_dwordx4 v[52:55], v1, s[8:11], s25 offen offset:3072 nt
  buffer_load_dwordx4 v[56:59], v1, s[8:11], s25 offen offset:3200 nt
  buffer_load_dwordx4 v[60:63], v1, s[8:11], s25 offen offset:3328 nt
  v_add_f32_dpp v112, v112, v112 quad_perm:[1,0,3,2] row_mask:0xf bank_mask:0xf
  v_add_f32_dpp v113, v113, v113 quad_perm:[1,0,3,2] row_mask:0xf bank_mask:0xf
  v_add_f32_dpp v114, v114, v114 quad_perm:[1,0,3,2] row_mask:0xf bank_mask:0xf
  v_add_f32_dpp v115, v115, v115 quad_perm:[1,0,3,2] row_mask:0xf bank_mask:0xf
  v_add_f32_dpp v112, v112, v112 quad_perm:[2,3,0,1] row_mask:0xf bank_mask:0xf
  v_add_f32_dpp v113, v113, v113 quad_perm:[2,3,0,1] row_mask:0xf bank_mask:0xf
  v_add_f32_dpp v114, v114, v114 quad_perm:[2,3,0,1] row_mask:0xf bank_mask:0xf
  v_add_f32_dpp v115, v115, v115 quad_perm:[2,3,0,1] row_mask:0xf bank_mask:0xf
  v_add_f32_dpp v112, v112, v112 row_half_mirror row_mask:0xf bank_mask:0xf
  v_add_f32_dpp v113, v113, v113 row_half_mirror row_mask:0xf bank_mask:0xf
  v_add_f32_dpp v114, v114, v114 row_half_mirror row_mask:0xf bank_mask:0xf
  v_add_f32_dpp v115, v115, v115 row_half_mirror row_mask:0xf bank_mask:0xf
  v_cvt_pk_bf16_f32 v116, v112, v113
  v_cvt_pk_bf16_f32 v117, v114, v115
  v_lshlrev_b32 v112, 16, v116
  v_and_b32 v113, 0xffff0000, v116
  v_lshlrev_b32 v114, 16, v117
  v_and_b32 v115, 0xffff0000, v117
  v_mul_f32 v112, 0x3d93cd3a, v112
  v_mul_f32 v113, 0x3d93cd3a, v113
  v_mul_f32 v114, 0x3d93cd3a, v114
  v_mul_f32 v115, 0x3d93cd3a, v115
  v_cvt_pk_bf16_f32 v116, v112, v113
  v_cvt_pk_bf16_f32 v117, v114, v115
  v_lshlrev_b32 v112, 16, v116
  v_and_b32 v113, 0xffff0000, v116
  v_lshlrev_b32 v114, 16, v117
  v_and_b32 v115, 0xffff0000, v117
  v_max3_f32 v116, v112, v113, v114
  v_max_f32 v116, v116, v115
  v_cmp_lt_f32 vcc, s30, v116
  s_nop 0
  s_cbranch_vccz L_nores_a
  v_max_f32_dpp v116, v116, v116 row_ror:8 row_mask:0xf bank_mask:0xf
  v_mov_b32 v117, v116
  s_nop 1
  v_permlane16_swap_b32 v116, v117
  v_max_f32 v116, v116, v117
  v_mov_b32 v117, v116
  s_nop 1
  v_permlane32_swap_b32 v116, v117
  v_max_f32 v116, v116, v117
  s_nop 0
  v_readfirstlane_b32 s30, v116
  v_mul_f32 v117, s31, v116
  v_sub_f32 v117, 0, v117
  v_sub_f32 v118, v117, v136
  v_exp_f32 v118, v118
  v_mov_b32 v136, v117
  v_mul_f32 v244, v244, v118
  v_mul_f32 v245, v245, v118
  v_mul_f32 v246, v246, v118
  v_mul_f32 v247, v247, v118
  v_mul_f32 v248, v248, v118
  v_mul_f32 v249, v249, v118
  v_mul_f32 v250, v250, v118
  v_mul_f32 v251, v251, v118
  v_mul_f32 v252, v252, v118
  v_mul_f32 v253, v253, v118
  v_mul_f32 v254, v254, v118
  v_mul_f32 v255, v255, v118
  v_mul_f32 v137, v137, v118
L_nores_a:
  v_fma_f32 v112, v112, s31, v136
  v_fma_f32 v113, v113, s31, v136
  v_fma_f32 v114, v114, s31, v136
  v_fma_f32 v115, v115, s31, v136
  v_exp_f32 v112, v112
  v_exp_f32 v113, v113
  v_exp_f32 v114, v114
  v_exp_f32 v115, v115
  v_cvt_pk_bf16_f32 v116, v112, v112
  v_cvt_pk_bf16_f32 v117, v113, v113
  v_cvt_pk_bf16_f32 v118, v114, v114
  v_cvt_pk_bf16_f32 v119, v115, v115
  v_add_f32 v137, v137, v112
  v_and_b32 v120, v116, v4
  v_and_b32 v121, v116, v5
  v_and_b32 v122, v116, v6
  v_and_b32 v123, v116, v7
  v_add_f32 v137, v137, v113
  v_and_b32 v124, v117, v4
  v_and_b32 v125, v117, v5
  v_and_b32 v126, v117, v6
  v_and_b32 v127, v117, v7
  v_add_f32 v137, v137, v114
  v_and_b32 v128, v118, v4
  v_and_b32 v129, v118, v5
  v_and_b32 v130, v118, v6
  v_and_b32 v131, v118, v7
  v_add_f32 v137, v137, v115
  v_and_b32 v132, v119, v4
  v_and_b32 v133, v119, v5
  v_and_b32 v134, v119, v6
  v_and_b32 v135, v119, v7
  s_waitcnt vmcnt(0)
  v_mfma_f32_16x16x32_bf16 v[244:247], v[64:67], v[120:123], v[244:247]
  v_mfma_f32_16x16x32_bf16 v[248:251], v[68:71], v[120:123], v[248:251]
  v_mfma_f32_16x16x32_bf16 v[252:255], v[72:75], v[120:123], v[252:255]
  buffer_load_dwordx4 v[64:67], v1, s[12:15], s24 offen offset:0 nt
  buffer_load_dwordx4 v[68:71], v1, s[12:15], s24 offen offset:128 nt
  buffer_load_dwordx4 v[72:75], v1, s[12:15], s24 offen offset:256 nt
  s_waitcnt vmcnt(0)
  v_mfma_f32_16x16x32_bf16 v[244:247], v[76:79], v[124:127], v[244:247]
  v_mfma_f32_16x16x32_bf16 v[248:251], v[80:83], v[124:127], v[248:251]
  v_mfma_f32_16x16x32_bf16 v[252:255], v[84:87], v[124:127], v[252:255]
  buffer_load_dwordx4 v[76:79], v1, s[12:15], s24 offen offset:3072 nt
  buffer_load_dwordx4 v[80:83], v1, s[12:15], s24 offen offset:3200 nt
  buffer_load_dwordx4 v[84:87], v1, s[12:15], s24 offen offset:3328 nt
  s_waitcnt vmcnt(0)
  v_mfma_f32_16x16x32_bf16 v[244:247], v[88:91], v[128:131], v[244:247]
  v_mfma_f32_16x16x32_bf16 v[248:251], v[92:95], v[128:131], v[248:251]
  v_mfma_f32_16x16x32_bf16 v[252:255], v[96:99], v[128:131], v[252:255]
  buffer_load_dwordx4 v[88:91], v1, s[12:15], s25 offen offset:0 nt
  buffer_load_dwordx4 v[92:95], v1, s[12:15], s25 offen offset:128 nt
  buffer_load_dwordx4 v[96:99], v1, s[12:15], s25 offen offset:256 nt
  s_waitcnt vmcnt(0)
  s_mov_b64 exec, 1
  ds_add_rtn_u32 v138, v140, v139 offset:3328
  s_mov_b64 exec, -1
  v_mfma_f32_16x16x32_bf16 v[244:247], v[100:103], v[132:135], v[244:247]
  v_mfma_f32_16x16x32_bf16 v[248:251], v[104:107], v[132:135], v[248:251]
  v_mfma_f32_16x16x32_bf16 v[252:255], v[108:111], v[132:135], v[252:255]
  buffer_load_dwordx4 v[100:103], v1, s[12:15], s25 offen offset:3072 nt
  buffer_load_dwordx4 v[104:107], v1, s[12:15], s25 offen offset:3200 nt
  buffer_load_dwordx4 v[108:111], v1, s[12:15], s25 offen offset:3328 nt
  s_waitcnt lgkmcnt(0)
  v_readfirstlane_b32 s27, v138
  s_branch L_loop
L_loop2:
  s_cmp_ge_u32 s27, s28
  s_cbranch_scc1 L_last
  s_lshr_b32 s24, s27, 3
  s_mul_i32 s24, s24, 786432
  s_and_b32 s25, s27, 7
  s_mul_i32 s25, s25, 12288
  s_add_u32 s24, s24, s25
  s_add_u32 s24, s24, s29
  s_add_u32 s25, s24, 6144
  s_waitcnt vmcnt(3)
  v_dot2_f32_bf16 v112, v16, v232, 0
  v_dot2_f32_bf16 v112, v17, v233, v112
  v_dot2_f32_bf16 v112, v18, v234, v112
  v_dot2_f32_bf16 v112, v19, v235, v112
  v_dot2_f32_bf16 v112, v20, v236, v112
  v_dot2_f32_bf16 v112, v21, v237, v112
  v_dot2_f32_bf16 v112, v22, v238, v112
  v_dot2_f32_bf16 v112, v23, v239, v112
  v_dot2_f32_bf16 v112, v24, v240, v112
  v_dot2_f32_bf16 v112, v25, v241, v112
  v_dot2_f32_bf16 v112, v26, v242, v112
  v_dot2_f32_bf16 v112, v27, v243, v112
  buffer_load_dwordx4 v[16:19], v1, s[8:11], s24 offen offset:0 nt
  buffer_load_dwordx4 v[20:23], v1, s[8:11], s24 offen offset:128 nt
  buffer_load_dwordx4 v[24:27], v1, s[8:11], s24 offen offset:256 nt
  s_waitcnt vmcnt(3)
  v_dot2_f32_bf16 v113, v28, v232, 0
  v_dot2_f32_bf16 v113, v29, v233, v113
  v_dot2_f32_bf16 v113, v30, v234, v113
  v_dot2_f32_bf16 v113, v31, v235, v113
  v_dot2_f32_bf16 v113, v32, v236, v113
  v_dot2_f32_bf16 v113, v33, v237, v113
  v_dot2_f32_bf16 v113, v34, v238, v113
  v_dot2_f32_bf16 v113, v35, v239, v113
  v_dot2_f32_bf16 v113, v36, v240, v113
  v_dot2_f32_bf16 v113, v37, v241, v113
  v_dot2_f32_bf16 v113, v38, v242, v113
  v_dot2_f32_bf16 v113, v39, v243, v113
  buffer_load_dwordx4 v[28:31], v1, s[8:11], s24 offen offset:3072 nt
  buffer_load_dwordx4 v[32:35], v1, s[8:11], s24 offen offset:3200 nt
  buffer_load_dwordx4 v[36:39], v1, s[8:11], s24 offen offset:3328 nt
  s_waitcnt vmcnt(3)
  v_dot2_f32_bf16 v114, v40, v232, 0
  v_dot2_f32_bf16 v114, v41, v233, v114
  v_dot2_f32_bf16 v114, v42, v234, v114
  v_dot2_f32_bf16 v114, v43, v235, v114
  v_dot2_f32_bf16 v114, v44, v236, v114
  v_dot2_f32_bf16 v114, v45, v237, v114
  v_dot2_f32_bf16 v114, v46, v238, v114
  v_dot2_f32_bf16 v114, v47, v239, v114
  v_dot2_f32_bf16 v114, v48, v240, v114
  v_dot2_f32_bf16 v114, v49, v241, v114
  v_dot2_f32_bf16 v114, v50, v242, v114
  v_dot2_f32_bf16 v114, v51, v243, v114
  buffer_load_dwordx4 v[40:43], v1, s[8:11], s25 offen offset:0 nt
  buffer_load_dwordx4 v[44:47], v1, s[8:11], s25 offen offset:128 nt
  buffer_load_dwordx4 v[48:51], v1, s[8:11], s25 offen offset:256 nt
  s_waitcnt vmcnt(3)
  v_dot2_f32_bf16 v115, v52, v232, 0
  v_dot2_f32_bf16 v115, v53, v233, v115
  v_dot2_f32_bf16 v115, v54, v234, v115
  v_dot2_f32_bf16 v115, v55, v235, v115
  v_dot2_f32_bf16 v115, v56, v236, v115
  v_dot2_f32_bf16 v115, v57, v237, v115
  v_dot2_f32_bf16 v115, v58, v238, v115
  v_dot2_f32_bf16 v115, v59, v239, v115
  v_dot2_f32_bf16 v115, v60, v240, v115
  v_dot2_f32_bf16 v115, v61, v241, v115
  v_dot2_f32_bf16 v115, v62, v242, v115
  v_dot2_f32_bf16 v115, v63, v243, v115
  buffer_load_dwordx4 v[52:55], v1, s[8:11], s25 offen offset:3072 nt
  buffer_load_dwordx4 v[56:59], v1, s[8:11], s25 offen offset:3200 nt
  buffer_load_dwordx4 v[60:63], v1, s[8:11], s25 offen offset:3328 nt
  v_add_f32_dpp v112, v112, v112 quad_perm:[1,0,3,2] row_mask:0xf bank_mask:0xf
  v_add_f32_dpp v113, v113, v113 quad_perm:[1,0,3,2] row_mask:0xf bank_mask:0xf
  v_add_f32_dpp v114, v114, v114 quad_perm:[1,0,3,2] row_mask:0xf bank_mask:0xf
  v_add_f32_dpp v115, v115, v115 quad_perm:[1,0,3,2] row_mask:0xf bank_mask:0xf
  v_add_f32_dpp v112, v112, v112 quad_perm:[2,3,0,1] row_mask:0xf bank_mask:0xf
  v_add_f32_dpp v113, v113, v113 quad_perm:[2,3,0,1] row_mask:0xf bank_mask:0xf
  v_add_f32_dpp v114, v114, v114 quad_perm:[2,3,0,1] row_mask:0xf bank_mask:0xf
  v_add_f32_dpp v115, v115, v115 quad_perm:[2,3,0,1] row_mask:0xf bank_mask:0xf
  v_add_f32_dpp v112, v112, v112 row_half_mirror row_mask:0xf bank_mask:0xf
  v_add_f32_dpp v113, v113, v113 row_half_mirror row_mask:0xf bank_mask:0xf
  v_add_f32_dpp v114, v114, v114 row_half_mirror row_mask:0xf bank_mask:0xf
  v_add_f32_dpp v115, v115, v115 row_half_mirror row_mask:0xf bank_mask:0xf
  v_cvt_pk_bf16_f32 v116, v112, v113
  v_cvt_pk_bf16_f32 v117, v114, v115
  v_lshlrev_b32 v112, 16, v116
  v_and_b32 v113, 0xffff0000, v116
  v_lshlrev_b32 v114, 16, v117
  v_and_b32 v115, 0xffff0000, v117
  v_mul_f32 v112, 0x3d93cd3a, v112
  v_mul_f32 v113, 0x3d93cd3a, v113
  v_mul_f32 v114, 0x3d93cd3a, v114
  v_mul_f32 v115, 0x3d93cd3a, v115
  v_cvt_pk_bf16_f32 v116, v112, v113
  v_cvt_pk_bf16_f32 v117, v114, v115
  v_lshlrev_b32 v112, 16, v116
  v_and_b32 v113, 0xffff0000, v116
  v_lshlrev_b32 v114, 16, v117
  v_and_b32 v115, 0xffff0000, v117
  v_max3_f32 v116, v112, v113, v114
  v_max_f32 v116, v116, v115
  v_cmp_lt_f32 vcc, s30, v116
  s_nop 0
  s_cbranch_vccz L_nores_c
  v_max_f32_dpp v116, v116, v116 row_ror:8 row_mask:0xf bank_mask:0xf
  v_mov_b32 v117, v116
  s_nop 1
  v_permlane16_swap_b32 v116, v117
  v_max_f32 v116, v116, v117
  v_mov_b32 v117, v116
  s_nop 1
  v_permlane32_swap_b32 v116, v117
  v_max_f32 v116, v116, v117
  s_nop 0
  v_readfirstlane_b32 s30, v116
  v_mul_f32 v117, s31, v116
  v_sub_f32 v117, 0, v117
  v_sub_f32 v118, v117, v136
  v_exp_f32 v118, v118
  v_mov_b32 v136, v117
  v_mul_f32 v244, v244, v118
  v_mul_f32 v245, v245, v118
  v_mul_f32 v246, v246, v118
  v_mul_f32 v247, v247, v118
  v_mul_f32 v248, v248, v118
  v_mul_f32 v249, v249, v118
  v_mul_f32 v250, v250, v118
  v_mul_f32 v251, v251, v118
  v_mul_f32 v252, v252, v118
  v_mul_f32 v253, v253, v118
  v_mul_f32 v254, v254, v118
  v_mul_f32 v255, v255, v118
  v_mul_f32 v137, v137, v118
L_nores_c:
  v_fma_f32 v112, v112, s31, v136
  v_fma_f32 v113, v113, s31, v136
  v_fma_f32 v114, v114, s31, v136
  v_fma_f32 v115, v115, s31, v136
  v_exp_f32 v112, v112
  v_exp_f32 v113, v113
  v_exp_f32 v114, v114
  v_exp_f32 v115, v115
  v_cvt_pk_bf16_f32 v116, v112, v112
  v_cvt_pk_bf16_f32 v117, v113, v113
  v_cvt_pk_bf16_f32 v118, v114, v114
  v_cvt_pk_bf16_f32 v119, v115, v115
  v_add_f32 v137, v137, v112
  v_and_b32 v120, v116, v4
  v_and_b32 v121, v116, v5
  v_and_b32 v122, v116, v6
  v_and_b32 v123, v116, v7
  v_add_f32 v137, v137, v113
  v_and_b32 v124, v117, v4
  v_and_b32 v125, v117, v5
  v_and_b32 v126, v117, v6
  v_and_b32 v127, v117, v7
  v_add_f32 v137, v137, v114
  v_and_b32 v128, v118, v4
  v_and_b32 v129, v118, v5
  v_and_b32 v130, v118, v6
  v_and_b32 v131, v118, v7
  v_add_f32 v137, v137, v115
  v_and_b32 v132, v119, v4
  v_and_b32 v133, v119, v5
  v_and_b32 v134, v119, v6
  v_and_b32 v135, v119, v7
  s_waitcnt vmcnt(3)
  v_mfma_f32_16x16x32_bf16 v[244:247], v[64:67], v[120:123], v[244:247]
  v_mfma_f32_16x16x32_bf16 v[248:251], v[68:71], v[120:123], v[248:251]
  v_mfma_f32_16x16x32_bf16 v[252:255], v[72:75], v[120:123], v[252:255]
  buffer_load_dwordx4 v[64:67], v1, s[12:15], s24 offen offset:0 nt
  buffer_load_dwordx4 v[68:71], v1, s[12:15], s24 offen offset:128 nt
  buffer_load_dwordx4 v[72:75], v1, s[12:15], s24 offen offset:256 nt
  s_waitcnt vmcnt(3)
  v_mfma_f32_16x16x32_bf16 v[244:247], v[76:79], v[124:127], v[244:247]
  v_mfma_f32_16x16x32_bf16 v[248:251], v[80:83], v[124:127], v[248:251]
  v_mfma_f32_16x16x32_bf16 v[252:255], v[84:87], v[124:127], v[252:255]
  buffer_load_dwordx4 v[76:79], v1, s[12:15], s24 offen offset:3072 nt
  buffer_load_dwordx4 v[80:83], v1, s[12:15], s24 offen offset:3200 nt
  buffer_load_dwordx4 v[84:87], v1, s[12:15], s24 offen offset:3328 nt
  s_waitcnt vmcnt(3)
  v_mfma_f32_16x16x32_bf16 v[244:247], v[88:91], v[128:131], v[244:247]
  v_mfma_f32_16x16x32_bf16 v[248:251], v[92:95], v[128:131], v[248:251]
  v_mfma_f32_16x16x32_bf16 v[252:255], v[96:99], v[128:131], v[252:255]
  buffer_load_dwordx4 v[88:91], v1, s[12:15], s25 offen offset:0 nt
  buffer_load_dwordx4 v[92:95], v1, s[12:15], s25 offen offset:128 nt
  buffer_load_dwordx4 v[96:99], v1, s[12:15], s25 offen offset:256 nt
  s_waitcnt vmcnt(3)
  s_mov_b64 exec, 1
  ds_add_rtn_u32 v138, v140, v139 offset:3328
  s_mov_b64 exec, -1
  v_mfma_f32_16x16x32_bf16 v[244:247], v[100:103], v[132:135], v[244:247]
  v_mfma_f32_16x16x32_bf16 v[248:251], v[104:107], v[132:135], v[248:251]
  v_mfma_f32_16x16x32_bf16 v[252:255], v[108:111], v[132:135], v[252:255]
  buffer_load_dwordx4 v[100:103], v1, s[12:15], s25 offen offset:3072 nt
  buffer_load_dwordx4 v[104:107], v1, s[12:15], s25 offen offset:3200 nt
  buffer_load_dwordx4 v[108:111], v1, s[12:15], s25 offen offset:3328 nt
  s_waitcnt lgkmcnt(0)
  v_readfirstlane_b32 s27, v138
  s_branch L_loop2
L_last:
  s_cmp_lt_i32 s26, 0
  s_cbranch_scc1 L_havemid
  global_load_dword v176, v178, s[62:63] sc1
  global_load_dword v177, v178, s[62:63] offset:256 sc1
  s_cmp_lg_u32 s3, 1
  s_cbranch_scc1 L_noflag_last
  global_load_dword v179, v140, s[60:61] sc1
L_noflag_last:
L_havemid:
  s_setprio 0
  s_waitcnt vmcnt(21)
  v_dot2_f32_bf16 v112, v16, v232, 0
  v_dot2_f32_bf16 v112, v17, v233, v112
  v_dot2_f32_bf16 v112, v18, v234, v112
  v_dot2_f32_bf16 v112, v19, v235, v112
  v_dot2_f32_bf16 v112, v20, v236, v112
  v_dot2_f32_bf16 v112, v21, v237, v112
  v_dot2_f32_bf16 v112, v22, v238, v112
  v_dot2_f32_bf16 v112, v23, v239, v112
  v_dot2_f32_bf16 v112, v24, v240, v112
  v_dot2_f32_bf16 v112, v25, v241, v112
  v_dot2_f32_bf16 v112, v26, v242, v112
  v_dot2_f32_bf16 v112, v27, v243, v112
  s_waitcnt vmcnt(18)
  v_dot2_f32_bf16 v113, v28, v232, 0
  v_dot2_f32_bf16 v113, v29, v233, v113
  v_dot2_f32_bf16 v113, v30, v234, v113
  v_dot2_f32_bf16 v113, v31, v235, v113
  v_dot2_f32_bf16 v113, v32, v236, v113
  v_dot2_f32_bf16 v113, v33, v237, v113
  v_dot2_f32_bf16 v113, v34, v238, v113
  v_dot2_f32_bf16 v113, v35, v239, v113
  v_dot2_f32_bf16 v113, v36, v240, v113
  v_dot2_f32_bf16 v113, v37, v241, v113
  v_dot2_f32_bf16 v113, v38, v242, v113
  v_dot2_f32_bf16 v113, v39, v243, v113
  s_waitcnt vmcnt(15)
  v_dot2_f32_bf16 v114, v40, v232, 0
  v_dot2_f32_bf16 v114, v41, v233, v114
  v_dot2_f32_bf16 v114, v42, v234, v114
  v_dot2_f32_bf16 v114, v43, v235, v114
  v_dot2_f32_bf16 v114, v44, v236, v114
  v_dot2_f32_bf16 v114, v45, v237, v114
  v_dot2_f32_bf16 v114, v46, v238, v114
  v_dot2_f32_bf16 v114, v47, v239, v114
  v_dot2_f32_bf16 v114, v48, v240, v114
  v_dot2_f32_bf16 v114, v49, v241, v114
  v_dot2_f32_bf16 v114, v50, v242, v114
  v_dot2_f32_bf16 v114, v51, v243, v114
  s_waitcnt vmcnt(12)
  v_dot2_f32_bf16 v115, v52, v232, 0
  v_dot2_f32_bf16 v115, v53, v233, v115
  v_dot2_f32_bf16 v115, v54, v234, v115
  v_dot2_f32_bf16 v115, v55, v235, v115
  v_dot2_f32_bf16 v115, v56, v236, v115
  v_dot2_f32_bf16 v115, v57, v237, v115
  v_dot2_f32_bf16 v115, v58, v238, v115
  v_dot2_f32_bf16 v115, v59, v239, v115
  v_dot2_f32_bf16 v115, v60, v240, v115
  v_dot2_f32_bf16 v115, v61, v241, v115
  v_dot2_f32_bf16 v115, v62, v242, v115
  v_dot2_f32_bf16 v115, v63, v243, v115
  v_add_f32_dpp v112, v112, v112 quad_perm:[1,0,3,2] row_mask:0xf bank_mask:0xf
  v_add_f32_dpp v113, v113, v113 quad_perm:[1,0,3,2] row_mask:0xf bank_mask:0xf
  v_add_f32_dpp v114, v114, v114 quad_perm:[1,0,3,2] row_mask:0xf bank_mask:0xf
  v_add_f32_dpp v115, v115, v115 quad_perm:[1,0,3,2] row_mask:0xf bank_mask:0xf
  v_add_f32_dpp v112, v112, v112 quad_perm:[2,3,0,1] row_mask:0xf bank_mask:0xf
  v_add_f32_dpp v113, v113, v113 quad_perm:[2,3,0,1] row_mask:0xf bank_mask:0xf
  v_add_f32_dpp v114, v114, v114 quad_perm:[2,3,0,1] row_mask:0xf bank_mask:0xf
  v_add_f32_dpp v115, v115, v115 quad_perm:[2,3,0,1] row_mask:0xf bank_mask:0xf
  v_add_f32_dpp v112, v112, v112 row_half_mirror row_mask:0xf bank_mask:0xf
  v_add_f32_dpp v113, v113, v113 row_half_mirror row_mask:0xf bank_mask:0xf
  v_add_f32_dpp v114, v114, v114 row_half_mirror row_mask:0xf bank_mask:0xf
  v_add_f32_dpp v115, v115, v115 row_half_mirror row_mask:0xf bank_mask:0xf
  v_cvt_pk_bf16_f32 v116, v112, v113
  v_cvt_pk_bf16_f32 v117, v114, v115
  v_lshlrev_b32 v112, 16, v116
  v_and_b32 v113, 0xffff0000, v116
  v_lshlrev_b32 v114, 16, v117
  v_and_b32 v115, 0xffff0000, v117
  v_mul_f32 v112, 0x3d93cd3a, v112
  v_mul_f32 v113, 0x3d93cd3a, v113
  v_mul_f32 v114, 0x3d93cd3a, v114
  v_mul_f32 v115, 0x3d93cd3a, v115
  v_cvt_pk_bf16_f32 v116, v112, v113
  v_cvt_pk_bf16_f32 v117, v114, v115
  v_lshlrev_b32 v112, 16, v116
  v_and_b32 v113, 0xffff0000, v116
  v_lshlrev_b32 v114, 16, v117
  v_and_b32 v115, 0xffff0000, v117
  v_max3_f32 v116, v112, v113, v114
  v_max_f32 v116, v116, v115
  v_cmp_lt_f32 vcc, s30, v116
  s_nop 0
  s_cbranch_vccz L_nores_b
  v_max_f32_dpp v116, v116, v116 row_ror:8 row_mask:0xf bank_mask:0xf
  v_mov_b32 v117, v116
  s_nop 1
  v_permlane16_swap_b32 v116, v117
  v_max_f32 v116, v116, v117
  v_mov_b32 v117, v116
  s_nop 1
  v_permlane32_swap_b32 v116, v117
  v_max_f32 v116, v116, v117
  s_nop 0
  v_readfirstlane_b32 s30, v116
  v_mul_f32 v117, s31, v116
  v_sub_f32 v117, 0, v117
  v_sub_f32 v118, v117, v136
  v_exp_f32 v118, v118
  v_mov_b32 v136, v117
  v_mul_f32 v244, v244, v118
  v_mul_f32 v245, v245, v118
  v_mul_f32 v246, v246, v118
  v_mul_f32 v247, v247, v118
  v_mul_f32 v248, v248, v118
  v_mul_f32 v249, v249, v118
  v_mul_f32 v250, v250, v118
  v_mul_f32 v251, v251, v118
  v_mul_f32 v252, v252, v118
  v_mul_f32 v253, v253, v118
  v_mul_f32 v254, v254, v118
  v_mul_f32 v255, v255, v118
  v_mul_f32 v137, v137, v118
L_nores_b:
  v_fma_f32 v112, v112, s31, v136
  v_fma_f32 v113, v113, s31, v136
  v_fma_f32 v114, v114, s31, v136
  v_fma_f32 v115, v115, s31, v136
  v_exp_f32 v112, v112
  v_exp_f32 v113, v113
  v_exp_f32 v114, v114
  v_exp_f32 v115, v115
  v_cvt_pk_bf16_f32 v116, v112, v112
  v_cvt_pk_bf16_f32 v117, v113, v113
  v_cvt_pk_bf16_f32 v118, v114, v114
  v_cvt_pk_bf16_f32 v119, v115, v115
  v_add_f32 v137, v137, v112
  v_and_b32 v120, v116, v4
  v_and_b32 v121, v116, v5
  v_and_b32 v122, v116, v6
  v_and_b32 v123, v116, v7
  v_add_f32 v137, v137, v113
  v_and_b32 v124, v117, v4
  v_and_b32 v125, v117, v5
  v_and_b32 v126, v117, v6
  v_and_b32 v127, v117, v7
  v_add_f32 v137, v137, v114
  v_and_b32 v128, v118, v4
  v_and_b32 v129, v118, v5
  v_and_b32 v130, v118, v6
  v_and_b32 v131, v118, v7
  v_add_f32 v137, v137, v115
  v_and_b32 v132, v119, v4
  v_and_b32 v133, v119, v5
  v_and_b32 v134, v119, v6
  v_and_b32 v135, v119, v7
  s_waitcnt vmcnt(9)
  v_mfma_f32_16x16x32_bf16 v[244:247], v[64:67], v[120:123], v[244:247]
  v_mfma_f32_16x16x32_bf16 v[248:251], v[68:71], v[120:123], v[248:251]
  v_mfma_f32_16x16x32_bf16 v[252:255], v[72:75], v[120:123], v[252:255]
  s_waitcnt vmcnt(6)
  v_mfma_f32_16x16x32_bf16 v[244:247], v[76:79], v[124:127], v[244:247]
  v_mfma_f32_16x16x32_bf16 v[248:251], v[80:83], v[124:127], v[248:251]
  v_mfma_f32_16x16x32_bf16 v[252:255], v[84:87], v[124:127], v[252:255]
  s_waitcnt vmcnt(3)
  v_mfma_f32_16x16x32_bf16 v[244:247], v[88:91], v[128:131], v[244:247]
  v_mfma_f32_16x16x32_bf16 v[248:251], v[92:95], v[128:131], v[248:251]
  v_mfma_f32_16x16x32_bf16 v[252:255], v[96:99], v[128:131], v[252:255]
  s_waitcnt vmcnt(0)
  v_mfma_f32_16x16x32_bf16 v[244:247], v[100:103], v[132:135], v[244:247]
  v_mfma_f32_16x16x32_bf16 v[248:251], v[104:107], v[132:135], v[248:251]
  v_mfma_f32_16x16x32_bf16 v[252:255], v[108:111], v[132:135], v[252:255]
  v_add_f32_dpp v137, v137, v137 row_ror:8 row_mask:0xf bank_mask:0xf
  v_mov_b32 v116, v137
  s_nop 1
  v_permlane16_swap_b32 v137, v116
  v_add_f32 v137, v137, v116
  v_mov_b32 v116, v137
  s_nop 1
  v_permlane32_swap_b32 v137, v116
  v_add_f32 v137, v137, v116
  v_sub_f32 v117, 0, v136
  s_lshl_b32 s40, s3, 3
  v_mov_b32 v8, s40
  ds_write_b32 v8, v117 offset:3200
  ds_write_b32 v8, v137 offset:3204
  v_lshrrev_b32 v9, 5, v0
  s_lshl_b32 s40, s3, 1
  v_add_u32 v9, s40, v9
  v_mul_u32_u24 v9, 784, v9
  v_bfe_u32 v8, v0, 4, 1
  v_lshl_add_u32 v9, v8, 7, v9
  v_lshl_add_u32 v9, v3, 2, v9
  v_add_u32 v9, 4096, v9
  s_mov_b32 exec_lo, 0x00ff00ff
  s_mov_b32 exec_hi, 0xff00ff00
  ds_write2_b32 v9, v244, v245 offset0:0 offset1:8
  ds_write2_b32 v9, v246, v247 offset0:16 offset1:24
  ds_write2_b32 v9, v248, v249 offset0:64 offset1:72
  ds_write2_b32 v9, v250, v251 offset0:80 offset1:88
  ds_write2_b32 v9, v252, v253 offset0:128 offset1:136
  ds_write2_b32 v9, v254, v255 offset0:144 offset1:152
  s_mov_b64 exec, -1
  v_lshlrev_b32 v32, 3, v3
  s_mul_i32 s40, s3, 96
  s_add_u32 s40, s40, 4096
  v_mul_u32_u24 v33, 1568, v3
  v_lshl_add_u32 v33, v2, 2, v33
  v_add_u32 v33, s40, v33
  s_lshl_b32 s40, s32, 13
  s_lshl_b32 s41, s3, 10
  s_add_u32 s40, s40, s41
  s_lshl_b32 s41, s33, 7
  s_add_u32 s40, s40, s41
  v_lshl_add_u32 v34, v2, 4, s40
  s_mov_b32 s44, 0xff00ff00
  s_mov_b32 s45, 0xff00ff00
  s_lshl_b32 s40, s32, 13
  s_lshl_b32 s41, s3, 10
  s_add_u32 s40, s40, s41
  v_lshl_add_u32 v63, v3, 7, s40
  v_lshl_add_u32 v63, v2, 4, v63
  v_cmp_ne_u32 s[42:43], s33, v3
  v_mov_b32 v16, -1
  v_mov_b32 v17, -1
  v_mov_b32 v18, -1
  v_mov_b32 v19, -1
  s_waitcnt lgkmcnt(0)
  s_barrier
  s_mov_b64 exec, s[42:43]
  global_load_dwordx4 v[16:19], v63, s[62:63] sc1
  s_mov_b64 exec, -1
  ds_read_b64 v[36:37], v32 offset:3200
  ds_read2_b32 v[44:45], v33 offset0:0 offset1:196
  ds_read2_b32 v[46:47], v33 offset0:8 offset1:204
  ds_read2_b32 v[48:49], v33 offset0:16 offset1:212
  s_waitcnt lgkmcnt(3)
  v_max_f32_dpp v38, v36, v36 quad_perm:[1,0,3,2] row_mask:0xf bank_mask:0xf
  s_nop 1
  v_max_f32_dpp v38, v38, v38 quad_perm:[2,3,0,1] row_mask:0xf bank_mask:0xf
  s_nop 1
  v_max_f32_dpp v38, v38, v38 row_half_mirror row_mask:0xf bank_mask:0xf
  v_sub_f32 v36, v36, v38
  v_exp_f32 v36, v36
  s_waitcnt lgkmcnt(0)
  v_add_f32 v40, v44, v45
  v_add_f32 v41, v46, v47
  v_add_f32 v42, v48, v49
  v_mul_f32 v37, v37, v36
  v_mul_f32 v40, v40, v36
  v_mul_f32 v41, v41, v36
  v_mul_f32 v42, v42, v36
  v_add_f32_dpp v37, v37, v37 quad_perm:[1,0,3,2] row_mask:0xf bank_mask:0xf
  v_add_f32_dpp v40, v40, v40 quad_perm:[1,0,3,2] row_mask:0xf bank_mask:0xf
  v_add_f32_dpp v41, v41, v41 quad_perm:[1,0,3,2] row_mask:0xf bank_mask:0xf
  v_add_f32_dpp v42, v42, v42 quad_perm:[1,0,3,2] row_mask:0xf bank_mask:0xf
  v_add_f32_dpp v37, v37, v37 quad_perm:[2,3,0,1] row_mask:0xf bank_mask:0xf
  v_add_f32_dpp v40, v40, v40 quad_perm:[2,3,0,1] row_mask:0xf bank_mask:0xf
  v_add_f32_dpp v41, v41, v41 quad_perm:[2,3,0,1] row_mask:0xf bank_mask:0xf
  v_add_f32_dpp v42, v42, v42 quad_perm:[2,3,0,1] row_mask:0xf bank_mask:0xf
  v_add_f32_dpp v37, v37, v37 row_half_mirror row_mask:0xf bank_mask:0xf
  v_add_f32_dpp v40, v40, v40 row_half_mirror row_mask:0xf bank_mask:0xf
  v_add_f32_dpp v41, v41, v41 row_half_mirror row_mask:0xf bank_mask:0xf
  v_add_f32_dpp v42, v42, v42 row_half_mirror row_mask:0xf bank_mask:0xf
  v_cndmask_b32 v43, v38, v37, s[44:45]
  s_mov_b32 exec_lo, 0x01010101
  s_mov_b32 exec_hi, 0x01010101
  global_store_dwordx4 v34, v[40:43], s[62:63] sc1
  s_mov_b64 exec, -1
  s_cmp_lg_u32 s3, 1
  s_cbranch_scc1 L_bar2
L_arrive:
  s_mov_b32 s46, 0
L_cleared:
  v_readfirstlane_b32 s40, v179
  s_nop 0
  s_cmp_ge_u32 s40, 8
  s_cbranch_scc1 L_cleared_done
  s_cmp_ge_u32 s46, 40000
  s_cbranch_scc1 L_cleared_done
  s_add_u32 s46, s46, 1
  s_sleep 8
  global_load_dword v179, v140, s[60:61] sc1
  s_waitcnt vmcnt(0)
  s_branch L_cleared
L_cleared_done:
  s_mul_i32 s40, s33, 4352
  s_add_u32 s40, s40, 655360
  v_mov_b32 v9, s40
  s_mov_b64 exec, 1
  global_atomic_add v9, v139, s[62:63] sc1
  s_mov_b64 exec, -1
L_bar2:
  s_cmp_ge_u32 s3, 6
  s_cbranch_scc1 L_g2_zero
  s_mov_b32 s46, 0
L_gu:
  v_cmp_eq_u32 vcc, -1, v176
  v_cmp_eq_u32 s[40:41], -1, v177
  s_nop 0
  s_or_b64 vcc, vcc, s[40:41]
  s_cbranch_vccz L_gu_done
  s_cmp_ge_u32 s46, 20000
  s_cbranch_scc1 L_gu_done
  s_add_u32 s46, s46, 1
  global_load_dword v176, v178, s[62:63] sc1
  global_load_dword v177, v178, s[62:63] offset:256 sc1
  s_waitcnt vmcnt(0)
  s_branch L_gu
L_gu_done:
  v_add_f32_dpp v176, v176, v176 quad_perm:[1,0,3,2] row_mask:0xf bank_mask:0xf
  v_add_f32_dpp v177, v177, v177 quad_perm:[1,0,3,2] row_mask:0xf bank_mask:0xf
  s_nop 0
  v_add_f32_dpp v176, v176, v176 quad_perm:[2,3,0,1] row_mask:0xf bank_mask:0xf
  v_add_f32_dpp v177, v177, v177 quad_perm:[2,3,0,1] row_mask:0xf bank_mask:0xf
  s_nop 0
  v_add_f32_dpp v176, v176, v176 row_half_mirror row_mask:0xf bank_mask:0xf
  v_add_f32_dpp v177, v177, v177 row_half_mirror row_mask:0xf bank_mask:0xf
  v_cvt_pk_bf16_f32 v176, v176, v176
  v_and_b32 v176, 0xffff0000, v176
  v_cvt_pk_bf16_f32 v177, v177, v177
  v_and_b32 v177, 0xffff0000, v177
  v_mul_f32 v176, v176, v177
  v_cvt_pk_bf16_f32 v176, v176, v176
  v_and_b32 v44, v176, v4
  v_and_b32 v45, v176, v5
  v_and_b32 v46, v176, v6
  v_and_b32 v47, v176, v7
  s_nop 1
  v_mfma_f32_16x16x32_bf16 v[48:51], v[168:171], v[44:47], 0
  v_mfma_f32_16x16x32_bf16 v[52:55], v[172:175], v[44:47], 0
  s_branch L_g2_done
L_g2_zero:
  v_mov_b32 v48, 0
  v_mov_b32 v49, 0
  v_mov_b32 v50, 0
  v_mov_b32 v51, 0
  v_mov_b32 v52, 0
  v_mov_b32 v53, 0
  v_mov_b32 v54, 0
  v_mov_b32 v55, 0
L_g2_done:
  v_lshrrev_b32 v56, 5, v0
  s_lshl_b32 s40, s3, 1
  v_add_u32 v56, s40, v56
  v_mul_u32_u24 v56, 1024, v56
  v_bfe_u32 v57, v0, 4, 1
  v_lshl_add_u32 v56, v57, 7, v56
  v_lshl_add_u32 v56, v3, 2, v56
  v_add_u32 v56, 16640, v56
  s_lshr_b32 s40, s3, 2
  s_lshl_b32 s40, s40, 7
  v_add_u32 v56, s40, v56
  v_and_b32 v58, 31, v0
  s_lshl_b32 s40, s3, 5
  v_add_u32 v58, s40, v58
  v_lshlrev_b32 v57, 2, v58
  v_add_u32 v59, 192, v57
  v_cmp_gt_u32 vcc, 80, v58
  s_nop 1
  v_cndmask_b32 v57, v59, v57, vcc
  v_lshrrev_b32 v59, 5, v0
  v_mul_u32_u24 v59, 8320, v59
  v_add_u32 v57, v57, v59
  v_add_u32 v57, 16640, v57
  s_mul_i32 s40, s33, 20480
  s_add_u32 s40, s40, 262144
  s_mul_i32 s41, s32, 640
  s_add_u32 s40, s40, s41
  v_lshl_add_u32 v58, v58, 2, s40
  s_lshl_b32 s43, s32, 2
  s_lshl_b32 s42, s33, 6
  s_lshl_b32 s41, s33, 4
  s_add_u32 s41, s41, 448
  s_cmp_lt_u32 s43, 64
  s_cselect_b32 s42, s42, s41
  s_add_u32 s42, s42, s43
  v_bfe_u32 v62, v0, 2, 2
  v_add_u32 v62, s42, v62
  v_lshlrev_b32 v62, 1, v62
  buffer_load_ushort v61, v62, s[20:23], 0 offen
  s_mul_i32 s40, s33, 20480
  s_add_u32 s40, s40, 262144
  s_lshl_b32 s41, s32, 4
  s_add_u32 s40, s40, s41
  v_and_b32 v59, 31, v0
  v_mul_u32_u24 v59, 640, v59
  v_lshrrev_b32 v60, 5, v0
  v_mul_u32_u24 v60, 320, v60
  v_add3_u32 v59, v59, v60, s40
  s_mul_i32 s42, s33, 4352
  s_add_u32 s42, s42, 655360
  v_mov_b32 v60, s42
  s_mov_b32 s64, s58
  s_and_b32 s65, s59, 0xffff
  s_mov_b32 s66, 1280
  s_mov_b32 s67, 0x20000
  s_mov_b32 exec_lo, 0x00ff00ff
  s_mov_b32 exec_hi, 0xff00ff00
  ds_write2_b32 v56, v48, v49 offset0:128 offset1:136
  ds_write2_b32 v56, v50, v51 offset0:144 offset1:152
  ds_write2_b32 v56, v52, v53 offset0:192 offset1:200
  ds_write2_b32 v56, v54, v55 offset0:208 offset1:216
  s_mov_b64 exec, -1
  s_cmp_eq_u32 s3, 1
  s_cbranch_scc1 L_by1
  s_waitcnt vmcnt(2)
  s_branch L_by2
L_by1:
  s_waitcnt vmcnt(3)
L_by2:
  s_mov_b32 s46, 0
  v_cmp_eq_u32 vcc, s33, v3
  s_nop 1
  v_cndmask_b32 v16, v16, v40, vcc
  v_cndmask_b32 v17, v17, v41, vcc
  v_cndmask_b32 v18, v18, v42, vcc
  v_cndmask_b32 v19, v19, v43, vcc
  s_branch L_poll_a_look
L_poll_a:
  s_waitcnt vmcnt(0)
L_poll_a_look:
  v_cmp_eq_u32 vcc, -1, v16
  v_cmp_eq_u32 s[40:41], -1, v17
  s_nop 0
  s_or_b64 vcc, vcc, s[40:41]
  v_cmp_eq_u32 s[40:41], -1, v18
  s_nop 0
  s_or_b64 vcc, vcc, s[40:41]
  v_cmp_eq_u32 s[40:41], -1, v19
  s_nop 0
  s_or_b64 vcc, vcc, s[40:41]
  s_cbranch_vccz L_poll_a_done
  s_cmp_ge_u32 s46, 20000
  s_cbranch_scc1 L_poll_a_done
  s_add_u32 s46, s46, 1
  s_sleep 1
  s_mov_b64 exec, vcc
  global_load_dwordx4 v[16:19], v63, s[62:63] sc1
  s_mov_b64 exec, -1
  s_branch L_poll_a
L_poll_a_done:
  v_mov_b32_dpp v20, v19 row_ror:8 row_mask:0xf bank_mask:0xf
  v_cndmask_b32 v21, v19, v20, s[44:45]
  v_cndmask_b32 v22, v20, v19, s[44:45]
  s_nop 0
  v_max_f32_dpp v23, v21, v21 quad_perm:[1,0,3,2] row_mask:0xf bank_mask:0xf
  s_nop 1
  v_max_f32_dpp v23, v23, v23 quad_perm:[2,3,0,1] row_mask:0xf bank_mask:0xf
  s_nop 1
  v_max_f32_dpp v23, v23, v23 row_half_mirror row_mask:0xf bank_mask:0xf
  v_sub_f32 v21, v21, v23
  v_exp_f32 v21, v21
  s_nop 0
  v_mul_f32 v22, v22, v21
  v_mul_f32 v16, v16, v21
  v_mul_f32 v17, v17, v21
  v_mul_f32 v18, v18, v21
  v_add_f32_dpp v22, v22, v22 quad_perm:[1,0,3,2] row_mask:0xf bank_mask:0xf
  v_add_f32_dpp v16, v16, v16 quad_perm:[1,0,3,2] row_mask:0xf bank_mask:0xf
  v_add_f32_dpp v17, v17, v17 quad_perm:[1,0,3,2] row_mask:0xf bank_mask:0xf
  v_add_f32_dpp v18, v18, v18 quad_perm:[1,0,3,2] row_mask:0xf bank_mask:0xf
  v_add_f32_dpp v22, v22, v22 quad_perm:[2,3,0,1] row_mask:0xf bank_mask:0xf
  v_add_f32_dpp v16, v16, v16 quad_perm:[2,3,0,1] row_mask:0xf bank_mask:0xf
  v_add_f32_dpp v17, v17, v17 quad_perm:[2,3,0,1] row_mask:0xf bank_mask:0xf
  v_add_f32_dpp v18, v18, v18 quad_perm:[2,3,0,1] row_mask:0xf bank_mask:0xf
  v_add_f32_dpp v22, v22, v22 row_half_mirror row_mask:0xf bank_mask:0xf
  v_add_f32_dpp v16, v16, v16 row_half_mirror row_mask:0xf bank_mask:0xf
  v_add_f32_dpp v17, v17, v17 row_half_mirror row_mask:0xf bank_mask:0xf
  v_add_f32_dpp v18, v18, v18 row_half_mirror row_mask:0xf bank_mask:0xf
  v_rcp_f32 v23, v22
  s_nop 0
  v_fma_f32 v24, -v22, v23, 1.0
  v_fma_f32 v23, v24, v23, v23
  v_mul_f32 v16, v16, v23
  v_mul_f32 v17, v17, v23
  v_mul_f32 v18, v18, v23
  v_cvt_pk_bf16_f32 v16, v16, v16
  v_cvt_pk_bf16_f32 v17, v17, v17
  v_cvt_pk_bf16_f32 v18, v18, v18
  v_and_b32 v28, v16, v4
  v_and_b32 v29, v16, v5
  v_and_b32 v30, v16, v6
  v_and_b32 v31, v16, v7
  v_and_b32 v32, v17, v4
  v_and_b32 v33, v17, v5
  v_and_b32 v34, v17, v6
  v_and_b32 v35, v17, v7
  v_and_b32 v36, v18, v4
  v_and_b32 v37, v18, v5
  v_and_b32 v38, v18, v6
  v_and_b32 v39, v18, v7
  v_mfma_f32_16x16x32_bf16 v[244:247], v[144:147], v[28:31], 0
  v_mfma_f32_16x16x32_bf16 v[248:251], v[148:151], v[28:31], 0
  v_mfma_f32_16x16x32_bf16 v[244:247], v[152:155], v[32:35], v[244:247]
  v_mfma_f32_16x16x32_bf16 v[248:251], v[156:159], v[32:35], v[248:251]
  v_mfma_f32_16x16x32_bf16 v[244:247], v[160:163], v[36:39], v[244:247]
  v_mfma_f32_16x16x32_bf16 v[248:251], v[164:167], v[36:39], v[248:251]
  s_mov_b32 exec_lo, 0x00ff00ff
  s_mov_b32 exec_hi, 0xff00ff00
  s_nop 4
  ds_write2_b32 v56, v244, v245 offset0:0 offset1:8
  ds_write2_b32 v56, v246, v247 offset0:16 offset1:24
  ds_write2_b32 v56, v248, v249 offset0:64 offset1:72
  ds_write2_b32 v56, v250, v251 offset0:80 offset1:88
  s_mov_b64 exec, -1
  s_waitcnt lgkmcnt(0)
  s_barrier
  s_cmp_ge_u32 s3, 5
  s_cbranch_scc1 L_exit
  ds_read2st64_b32 v[32:33], v57 offset0:0 offset1:4
  ds_read2st64_b32 v[34:35], v57 offset0:8 offset1:12
  ds_read2st64_b32 v[36:37], v57 offset0:16 offset1:20
  ds_read2st64_b32 v[38:39], v57 offset0:24 offset1:28
  s_waitcnt lgkmcnt(2)
  v_add_f32 v32, v32, v33
  v_add_f32 v34, v34, v35
  v_add_f32 v32, v32, v34
  s_waitcnt lgkmcnt(0)
  v_add_f32 v36, v36, v37
  v_add_f32 v38, v38, v39
  v_add_f32 v36, v36, v38
  v_add_f32 v32, v32, v36
  v_mov_b32 v33, v32
  s_nop 1
  v_permlane32_swap_b32 v32, v33
  v_add_f32 v32, v32, v33
  s_mov_b32 exec_hi, 0
  global_store_dword v58, v32, s[62:63] sc1
  s_mov_b64 exec, -1
  s_cmp_lg_u32 s3, 0
  s_cbranch_scc1 L_exit
  s_cmp_ge_u32 s32, 20
  s_cbranch_scc1 L_exit
  s_mov_b32 s46, 0
  s_mov_b64 exec, 1
L_light:
  global_load_dword v11, v60, s[62:63] sc1
  s_waitcnt vmcnt(0)
  v_readfirstlane_b32 s40, v11
  s_nop 0
  s_cmp_ge_u32 s40, 32
  s_cbranch_scc1 L_light_done
  s_cmp_ge_u32 s46, 40000
  s_cbranch_scc1 L_light_done
  s_add_u32 s46, s46, 1
  s_sleep 8
  s_branch L_light
L_light_done:
  s_mov_b64 exec, -1
  v_lshlrev_b32 v61, 16, v61
  global_load_dwordx4 v[16:19], v59, s[62:63] sc1
  s_mov_b32 s46, 0
L_poll_b:
  s_waitcnt vmcnt(0)
  v_cmp_eq_u32 vcc, -1, v16
  v_cmp_eq_u32 s[40:41], -1, v17
  s_nop 0
  s_or_b64 vcc, vcc, s[40:41]
  v_cmp_eq_u32 s[40:41], -1, v18
  s_nop 0
  s_or_b64 vcc, vcc, s[40:41]
  v_cmp_eq_u32 s[40:41], -1, v19
  s_nop 0
  s_or_b64 vcc, vcc, s[40:41]
  s_cbranch_vccz L_poll_b_done
  s_cmp_ge_u32 s46, 20000
  s_cbranch_scc1 L_poll_b_done
  s_add_u32 s46, s46, 1
  s_sleep 1
  s_mov_b64 exec, vcc
  global_load_dwordx4 v[16:19], v59, s[62:63] sc1
  s_mov_b64 exec, -1
  s_branch L_poll_b
L_poll_b_done:
  v_add_f32_dpp v16, v16, v16 row_mirror row_mask:0xf bank_mask:0x3
  v_add_f32_dpp v17, v17, v17 row_mirror row_mask:0xf bank_mask:0x3
  s_nop 0
  v_add_f32_dpp v16, v18, v18 row_mirror row_mask:0xf bank_mask:0xc
  v_add_f32_dpp v17, v19, v19 row_mirror row_mask:0xf bank_mask:0xc
  s_nop 0
  v_add_f32_dpp v16, v16, v16 row_half_mirror row_mask:0xf bank_mask:0x5
  s_nop 1
  v_add_f32_dpp v16, v17, v17 row_half_mirror row_mask:0xf bank_mask:0xa
  s_nop 1
  v_add_f32_dpp v16, v16, v16 quad_perm:[1,0,3,2] row_mask:0xf bank_mask:0xf
  s_nop 1
  v_add_f32_dpp v16, v16, v16 quad_perm:[2,3,0,1] row_mask:0xf bank_mask:0xf
  v_mov_b32 v20, v16
  s_nop 1
  v_permlane16_swap_b32 v16, v20
  v_add_f32 v16, v16, v20
  v_mov_b32 v20, v16
  s_nop 1
  v_permlane32_swap_b32 v16, v20
  v_cvt_pk_bf16_f32 v16, v16, v16
  v_and_b32 v16, 0xffff0000, v16
  v_cvt_pk_bf16_f32 v20, v20, v20
  v_and_b32 v20, 0xffff0000, v20
  v_add_f32 v16, v61, v16
  v_cvt_pk_bf16_f32 v16, v16, v16
  v_and_b32 v16, 0xffff0000, v16
  v_add_f32 v16, v16, v20
  v_cvt_pk_bf16_f32 v16, v16, v16
  s_mov_b64 exec, 0x1111
  buffer_store_short v16, v62, s[64:67], 0 offen
L_exit:
L_done:
  s_endpgm
.section .rodata,"a"
.p2align 6
.amdhsa_kernel parallel_sum__mha_block_cached__glu_gated_bilinear__decode_kernel
  .amdhsa_next_free_vgpr 256
  .amdhsa_next_free_sgpr 102
  .amdhsa_accum_offset 256
  .amdhsa_group_segment_fixed_size 0
  .amdhsa_kernarg_size 96
  .amdhsa_user_sgpr_count 2
  .amdhsa_user_sgpr_kernarg_segment_ptr 1
  .amdhsa_system_sgpr_workgroup_id_x 1
.end_amdhsa_kernel
```
